```python
import torch

def _softmax(x, axis=-1):
    return torch.softmax(x, dim=axis)

def _gelu(x):
    return torch.nn.functional.gelu(x, approximate='tanh')

def _silu(x):
    return torch.nn.functional.silu(x)

def _sigmoid(x):
    return torch.sigmoid(x)

def _layernorm(x, axis=-1, eps=1e-05):
    m = x.mean(dim=axis, keepdim=True)
    v = x.var(dim=axis, keepdim=True, unbiased=False)
    return (x - m) / torch.sqrt(v + eps)

def _scatter_add(tgt, idx, src, axis=0):
    return tgt.clone().index_add_(axis, idx, src)

def _segment_sum(src, seg, n):
    out = torch.zeros((n,) + src.shape[1:], dtype=src.dtype)
    return out.index_add_(0, seg, src)

def _pad(x, pw):
    flat = tuple((v for pair in reversed(pw) for v in pair))
    return torch.nn.functional.pad(x, flat)
kernel_name = 'standalone__tree_speculative_verify_tree_attention_over_candidate_token_tree__sampling'

def setup_inputs():

    _w = lambda a: (lambda t: t.to(torch.bfloat16) if t.is_floating_point() else t)(torch.as_tensor(a))
    B, Hq, Hkv, T, C, D = (8, 32, 16, 16, 8192, 128)
    tree_mask = torch.zeros((B, T, T), dtype=float)
    for b in range(B):
        parent = torch.zeros(T, dtype=torch.int64)
        for i in range(1, T):
            parent[i] = int(torch.randint(0, i, (1,)).item())
        for i in range(T):
            j = i
            tree_mask[b, i, j] = 1.0
            while j > 0:
                j = parent[j]
                tree_mask[b, i, j] = 1.0
    return {'q': _w((lambda *s: torch.randn(*s, dtype=torch.bfloat16) * 0.8)(B, Hq, T, D)), 'k_cache': _w((lambda *s: torch.randn(*s, dtype=torch.bfloat16) * 0.8)(B, Hkv, C, D)), 'v_cache': _w((lambda *s: torch.randn(*s, dtype=torch.bfloat16) * 0.05)(B, Hkv, C, D)), 'k_tree': _w((lambda *s: torch.randn(*s, dtype=torch.bfloat16) * 0.8)(B, Hkv, T, D)), 'v_tree': _w((lambda *s: torch.randn(*s, dtype=torch.bfloat16) * 0.05)(B, Hkv, T, D)), 'tree_mask': _w(tree_mask)}

def reference(q, k_cache, v_cache, k_tree, v_tree, tree_mask):
    B, Hq, T, D = q.shape
    Hkv, C = (k_cache.shape[1], k_cache.shape[2])
    rep = Hq // Hkv
    kc = (lambda x, n, axis: torch.repeat_interleave(x, n, dim=axis))(k_cache, rep, axis=1)
    vc = (lambda x, n, axis: torch.repeat_interleave(x, n, dim=axis))(v_cache, rep, axis=1)
    kt = (lambda x, n, axis: torch.repeat_interleave(x, n, dim=axis))(k_tree, rep, axis=1)
    vt = (lambda x, n, axis: torch.repeat_interleave(x, n, dim=axis))(v_tree, rep, axis=1)
    k = torch.concatenate([kc, kt], axis=2)
    v = torch.concatenate([vc, vt], axis=2)
    scale = D ** (-0.5)
    scores = torch.einsum('bhqd,bhkd->bhqk', q, k) * scale
    ctx_mask = torch.ones((B, 1, T, C), dtype=scores.dtype)
    tm = tree_mask[:, None, :, :].clone()
    full_mask = torch.concatenate([ctx_mask, tm], axis=-1)
    scores = scores + (1.0 - full_mask) * -1000000000.0
    p = _softmax(scores, axis=-1)
    return torch.einsum('bhqk,bhkd->bhqd', p, v)
```

```asm
; @launch grid=(256,1,1) block=(512,1,1) lds=140288
.amdgcn_target "amdgcn-amd-amdhsa--gfx950"
.text
.globl standalone__tree_speculative_verify_tree_attention_over_candidate_token_tree__sampling_kernel
.p2align 8
.type standalone__tree_speculative_verify_tree_attention_over_candidate_token_tree__sampling_kernel,@function
standalone__tree_speculative_verify_tree_attention_over_candidate_token_tree__sampling_kernel:
    s_load_dwordx16 s[4:19], s[0:1], 0
    s_load_dwordx2 s[52:53], s[0:1], 64
    v_readfirstlane_b32 s3, v0
    s_cmp_ge_u32 s2, 256
    s_cbranch_scc1 L_end
    s_lshr_b32 s3, s3, 6
    s_cbranch_scc1 L_cons
    s_setprio 3
    v_and_b32 v96, 63, v0
    s_lshr_b32 s40, s2, 4
    s_lshl_b32 s40, s40, 3
    s_and_b32 s50, s2, 7
    s_or_b32 s40, s40, s50
    s_bfe_u32 s41, s2, 0x10003
    v_lshlrev_b32 v0, 4, v96
    v_and_b32 v100, 0x30, v96
    v_xor_b32 v40, v0, v100
    v_xor_b32 v41, 64, v40
    v_xor_b32 v42, 128, v40
    v_xor_b32 v43, 192, v40
    v_mov_b32 v45, v41
    v_add_u32 v41, 3072, v41
    v_mov_b32 v46, v42
    v_add_u32 v42, 6144, v42
    v_mov_b32 v47, v43
    v_add_u32 v43, 9216, v43
    s_lshl_b32 s50, s40, 13
    s_mov_b32 s30, 8192
    s_mov_b32 s31, 0x20000
    s_movk_i32 s51, 4096
    s_lshl_b32 s45, s40, 21
    s_mov_b32 s22, 0x200000
    s_mov_b32 s23, 0x20000
    s_mul_i32 s46, s41, 1024
    s_add_u32 s46, s46, 1998848
    s_mov_b32 s44, 0
    s_mov_b32 s47, 0
    s_waitcnt lgkmcnt(0)
    s_add_u32 s20, s6, s45
    s_addc_u32 s21, s7, 0
L_half:
    s_add_u32 m0, s44, 0
    s_add_u32 s43, s46, 0
    s_waitcnt vmcnt(31)
    buffer_load_dwordx4 v40, s[20:23], s43 offen offset:0 nt lds
    s_waitcnt vmcnt(31)
    buffer_load_dwordx4 v41, s[20:23], s43 offen offset:1024 nt lds
    s_waitcnt vmcnt(31)
    buffer_load_dwordx4 v42, s[20:23], s43 offen offset:2048 nt lds
    s_waitcnt vmcnt(31)
    buffer_load_dwordx4 v43, s[20:23], s43 offen offset:3072 nt lds
    s_add_u32 m0, s44, 4096
    s_add_u32 s43, s46, 16384
    s_waitcnt vmcnt(31)
    buffer_load_dwordx4 v40, s[20:23], s43 offen offset:0 nt lds
    s_waitcnt vmcnt(31)
    buffer_load_dwordx4 v41, s[20:23], s43 offen offset:1024 nt lds
    s_waitcnt vmcnt(31)
    buffer_load_dwordx4 v42, s[20:23], s43 offen offset:2048 nt lds
    s_waitcnt vmcnt(31)
    buffer_load_dwordx4 v43, s[20:23], s43 offen offset:3072 nt lds
    s_add_u32 m0, s44, 8192
    s_add_u32 s43, s46, 2048
    s_waitcnt vmcnt(31)
    buffer_load_dwordx4 v40, s[20:23], s43 offen offset:0 nt lds
    s_waitcnt vmcnt(31)
    buffer_load_dwordx4 v41, s[20:23], s43 offen offset:1024 nt lds
    s_waitcnt vmcnt(31)
    buffer_load_dwordx4 v42, s[20:23], s43 offen offset:2048 nt lds
    s_waitcnt vmcnt(31)
    buffer_load_dwordx4 v43, s[20:23], s43 offen offset:3072 nt lds
    s_add_u32 m0, s44, 12288
    s_add_u32 s43, s46, 18432
    s_waitcnt vmcnt(31)
    buffer_load_dwordx4 v40, s[20:23], s43 offen offset:0 nt lds
    s_waitcnt vmcnt(31)
    buffer_load_dwordx4 v41, s[20:23], s43 offen offset:1024 nt lds
    s_waitcnt vmcnt(31)
    buffer_load_dwordx4 v42, s[20:23], s43 offen offset:2048 nt lds
    s_waitcnt vmcnt(31)
    buffer_load_dwordx4 v43, s[20:23], s43 offen offset:3072 nt lds
    s_cmp_lg_u32 s47, 0
    s_cbranch_scc1 L_h2
    s_mov_b32 m0, 98304
    s_add_u32 s28, s4, s50
    s_addc_u32 s29, s5, 0
    buffer_load_dwordx4 v40, s[28:31], 0 offen offset:0 lds
    buffer_load_dwordx4 v45, s[28:31], 0 offen offset:1024 lds
    buffer_load_dwordx4 v46, s[28:31], 0 offen offset:2048 lds
    buffer_load_dwordx4 v47, s[28:31], 0 offen offset:3072 lds
    s_mov_b32 m0, 102400
    s_nop 0
    buffer_load_dwordx4 v40, s[28:31], s51 offen offset:0 lds
    buffer_load_dwordx4 v45, s[28:31], s51 offen offset:1024 lds
    buffer_load_dwordx4 v46, s[28:31], s51 offen offset:2048 lds
    buffer_load_dwordx4 v47, s[28:31], s51 offen offset:3072 lds
    s_lshl_b32 s48, s41, 16
    s_mov_b32 s42, s48
    s_mov_b32 s44, 32768
    s_add_u32 s95, s41, 31
    s_add_u32 s49, s95, 1
    s_mov_b32 s84, 0xd8618618
    s_mov_b32 s85, 0xaf663186
    s_mov_b32 s86, 0x10410410
    s_mov_b32 s87, 0xa442104
    s_mov_b32 s88, 1
    s_and_b32 s90, s2, 7
    s_mov_b32 s91, 65536
    s_lshr_b32 s89, s2, 3
    s_lshl_b32 s90, s90, 2
    s_add_u32 s90, s90, 3
    s_mov_b32 s92, -1
    s_and_b32 s50, s89, 28
    s_mul_i32 s50, s50, 64
    s_add_u32 s50, s50, s91
    s_add_u32 s98, s52, s50
    s_addc_u32 s99, s53, 0
    s_add_u32 s91, s91, 2048
    s_load_dword s97, s[98:99], 0 glc
L_lv1:
    s_add_u32 m0, s44, 0
    s_add_u32 s43, s42, 0
    s_waitcnt vmcnt(19)
    buffer_load_dwordx4 v40, s[20:23], s43 offen offset:0 nt lds
    s_waitcnt vmcnt(19)
    buffer_load_dwordx4 v41, s[20:23], s43 offen offset:1024 nt lds
    s_waitcnt vmcnt(19)
    buffer_load_dwordx4 v42, s[20:23], s43 offen offset:2048 nt lds
    s_waitcnt vmcnt(19)
    buffer_load_dwordx4 v43, s[20:23], s43 offen offset:3072 nt lds
    s_add_u32 m0, s44, 4096
    s_add_u32 s43, s42, 16384
    s_waitcnt vmcnt(19)
    buffer_load_dwordx4 v40, s[20:23], s43 offen offset:0 nt lds
    s_waitcnt vmcnt(19)
    buffer_load_dwordx4 v41, s[20:23], s43 offen offset:1024 nt lds
    s_waitcnt vmcnt(19)
    buffer_load_dwordx4 v42, s[20:23], s43 offen offset:2048 nt lds
    s_waitcnt vmcnt(19)
    buffer_load_dwordx4 v43, s[20:23], s43 offen offset:3072 nt lds
    s_add_u32 m0, s44, 8192
    s_add_u32 s43, s42, 2048
    s_waitcnt vmcnt(19)
    buffer_load_dwordx4 v40, s[20:23], s43 offen offset:0 nt lds
    s_waitcnt vmcnt(19)
    buffer_load_dwordx4 v41, s[20:23], s43 offen offset:1024 nt lds
    s_waitcnt vmcnt(19)
    buffer_load_dwordx4 v42, s[20:23], s43 offen offset:2048 nt lds
    s_waitcnt vmcnt(19)
    buffer_load_dwordx4 v43, s[20:23], s43 offen offset:3072 nt lds
    s_cmp_lg_u32 s47, s49
    s_cbranch_scc1 L_nx1
    s_barrier
L_nx1:
    s_add_u32 m0, s44, 12288
    s_add_u32 s43, s42, 18432
    s_waitcnt vmcnt(19)
    buffer_load_dwordx4 v40, s[20:23], s43 offen offset:0 nt lds
    s_waitcnt vmcnt(19)
    buffer_load_dwordx4 v41, s[20:23], s43 offen offset:1024 nt lds
    s_waitcnt vmcnt(19)
    buffer_load_dwordx4 v42, s[20:23], s43 offen offset:2048 nt lds
    s_waitcnt vmcnt(19)
    buffer_load_dwordx4 v43, s[20:23], s43 offen offset:3072 nt lds
    s_add_u32 m0, s44, 16384
    s_add_u32 s43, s42, 1024
    s_waitcnt vmcnt(19)
    buffer_load_dwordx4 v40, s[20:23], s43 offen offset:0 nt lds
    s_waitcnt vmcnt(19)
    buffer_load_dwordx4 v41, s[20:23], s43 offen offset:1024 nt lds
    s_waitcnt vmcnt(19)
    buffer_load_dwordx4 v42, s[20:23], s43 offen offset:2048 nt lds
    s_waitcnt vmcnt(19)
    buffer_load_dwordx4 v43, s[20:23], s43 offen offset:3072 nt lds
    s_barrier
    s_add_u32 m0, s44, 20480
    s_add_u32 s43, s42, 17408
    s_waitcnt vmcnt(19)
    buffer_load_dwordx4 v40, s[20:23], s43 offen offset:0 nt lds
    s_waitcnt vmcnt(19)
    buffer_load_dwordx4 v41, s[20:23], s43 offen offset:1024 nt lds
    s_waitcnt vmcnt(19)
    buffer_load_dwordx4 v42, s[20:23], s43 offen offset:2048 nt lds
    s_waitcnt vmcnt(19)
    buffer_load_dwordx4 v43, s[20:23], s43 offen offset:3072 nt lds
    s_add_u32 m0, s44, 24576
    s_add_u32 s43, s42, 3072
    s_waitcnt vmcnt(19)
    buffer_load_dwordx4 v40, s[20:23], s43 offen offset:0 nt lds
    s_waitcnt vmcnt(19)
    buffer_load_dwordx4 v41, s[20:23], s43 offen offset:1024 nt lds
    s_waitcnt vmcnt(19)
    buffer_load_dwordx4 v42, s[20:23], s43 offen offset:2048 nt lds
    s_waitcnt vmcnt(19)
    buffer_load_dwordx4 v43, s[20:23], s43 offen offset:3072 nt lds
    s_add_u32 m0, s44, 28672
    s_add_u32 s43, s42, 19456
    s_waitcnt vmcnt(19)
    buffer_load_dwordx4 v40, s[20:23], s43 offen offset:0 nt lds
    s_waitcnt vmcnt(19)
    buffer_load_dwordx4 v41, s[20:23], s43 offen offset:1024 nt lds
    s_waitcnt vmcnt(19)
    buffer_load_dwordx4 v42, s[20:23], s43 offen offset:2048 nt lds
    s_waitcnt vmcnt(19)
    buffer_load_dwordx4 v43, s[20:23], s43 offen offset:3072 nt lds
    s_add_u32 s44, s44, 32768
    s_cmp_eq_u32 s44, 98304
    s_cselect_b32 s44, 0, s44
    s_or_b32 s42, s42, 0xffe17fff
    s_add_u32 s42, s42, 1
    s_and_b32 s42, s42, 0x1e8000
    s_or_b32 s42, s42, s48
    s_add_u32 s50, s47, 1
    s_bitcmp1_b64 s[84:85], s47
    s_mov_b32 s47, s50
    s_cbranch_scc0 L_lv1
    s_branch L_event
L_lv0:
    s_add_u32 m0, s44, 0
    s_add_u32 s43, s42, 0
    s_waitcnt vmcnt(18)
    buffer_load_dwordx4 v40, s[20:23], s43 offen offset:0 nt lds
    s_waitcnt vmcnt(18)
    buffer_load_dwordx4 v41, s[20:23], s43 offen offset:1024 nt lds
    s_waitcnt vmcnt(18)
    buffer_load_dwordx4 v42, s[20:23], s43 offen offset:2048 nt lds
    s_waitcnt vmcnt(18)
    buffer_load_dwordx4 v43, s[20:23], s43 offen offset:3072 nt lds
    s_add_u32 m0, s44, 4096
    s_add_u32 s43, s42, 16384
    s_waitcnt vmcnt(18)
    buffer_load_dwordx4 v40, s[20:23], s43 offen offset:0 nt lds
    s_waitcnt vmcnt(18)
    buffer_load_dwordx4 v41, s[20:23], s43 offen offset:1024 nt lds
    s_waitcnt vmcnt(18)
    buffer_load_dwordx4 v42, s[20:23], s43 offen offset:2048 nt lds
    s_waitcnt vmcnt(18)
    buffer_load_dwordx4 v43, s[20:23], s43 offen offset:3072 nt lds
    s_add_u32 m0, s44, 8192
    s_add_u32 s43, s42, 2048
    s_waitcnt vmcnt(18)
    buffer_load_dwordx4 v40, s[20:23], s43 offen offset:0 nt lds
    s_waitcnt vmcnt(18)
    buffer_load_dwordx4 v41, s[20:23], s43 offen offset:1024 nt lds
    s_waitcnt vmcnt(18)
    buffer_load_dwordx4 v42, s[20:23], s43 offen offset:2048 nt lds
    s_waitcnt vmcnt(18)
    buffer_load_dwordx4 v43, s[20:23], s43 offen offset:3072 nt lds
    s_cmp_lg_u32 s47, s49
    s_cbranch_scc1 L_nx0
    s_barrier
L_nx0:
    s_add_u32 m0, s44, 12288
    s_add_u32 s43, s42, 18432
    s_waitcnt vmcnt(18)
    buffer_load_dwordx4 v40, s[20:23], s43 offen offset:0 nt lds
    s_waitcnt vmcnt(18)
    buffer_load_dwordx4 v41, s[20:23], s43 offen offset:1024 nt lds
    s_waitcnt vmcnt(18)
    buffer_load_dwordx4 v42, s[20:23], s43 offen offset:2048 nt lds
    s_waitcnt vmcnt(18)
    buffer_load_dwordx4 v43, s[20:23], s43 offen offset:3072 nt lds
    s_add_u32 m0, s44, 16384
    s_add_u32 s43, s42, 1024
    s_waitcnt vmcnt(18)
    buffer_load_dwordx4 v40, s[20:23], s43 offen offset:0 nt lds
    s_waitcnt vmcnt(18)
    buffer_load_dwordx4 v41, s[20:23], s43 offen offset:1024 nt lds
    s_waitcnt vmcnt(18)
    buffer_load_dwordx4 v42, s[20:23], s43 offen offset:2048 nt lds
    s_barrier
    s_waitcnt vmcnt(18)
    buffer_load_dwordx4 v43, s[20:23], s43 offen offset:3072 nt lds
    s_add_u32 m0, s44, 20480
    s_add_u32 s43, s42, 17408
    s_waitcnt vmcnt(18)
    buffer_load_dwordx4 v40, s[20:23], s43 offen offset:0 nt lds
    s_waitcnt vmcnt(18)
    buffer_load_dwordx4 v41, s[20:23], s43 offen offset:1024 nt lds
    s_waitcnt vmcnt(18)
    buffer_load_dwordx4 v42, s[20:23], s43 offen offset:2048 nt lds
    s_waitcnt vmcnt(18)
    buffer_load_dwordx4 v43, s[20:23], s43 offen offset:3072 nt lds
    s_add_u32 m0, s44, 24576
    s_add_u32 s43, s42, 3072
    s_waitcnt vmcnt(18)
    buffer_load_dwordx4 v40, s[20:23], s43 offen offset:0 nt lds
    s_waitcnt vmcnt(18)
    buffer_load_dwordx4 v41, s[20:23], s43 offen offset:1024 nt lds
    s_waitcnt vmcnt(18)
    buffer_load_dwordx4 v42, s[20:23], s43 offen offset:2048 nt lds
    s_waitcnt vmcnt(18)
    buffer_load_dwordx4 v43, s[20:23], s43 offen offset:3072 nt lds
    s_add_u32 m0, s44, 28672
    s_add_u32 s43, s42, 19456
    s_waitcnt vmcnt(18)
    buffer_load_dwordx4 v40, s[20:23], s43 offen offset:0 nt lds
    s_waitcnt vmcnt(18)
    buffer_load_dwordx4 v41, s[20:23], s43 offen offset:1024 nt lds
    s_waitcnt vmcnt(18)
    buffer_load_dwordx4 v42, s[20:23], s43 offen offset:2048 nt lds
    s_waitcnt vmcnt(18)
    buffer_load_dwordx4 v43, s[20:23], s43 offen offset:3072 nt lds
    s_add_u32 s44, s44, 32768
    s_cmp_eq_u32 s44, 98304
    s_cselect_b32 s44, 0, s44
    s_or_b32 s42, s42, 0xffe17fff
    s_add_u32 s42, s42, 1
    s_and_b32 s42, s42, 0x1e8000
    s_or_b32 s42, s42, s48
    s_add_u32 s50, s47, 1
    s_bitcmp1_b64 s[84:85], s47
    s_mov_b32 s47, s50
    s_cbranch_scc0 L_lv0
    s_branch L_event
L_lv2:
    s_add_u32 m0, s44, 0
    s_add_u32 s43, s42, 0
    s_waitcnt vmcnt(20)
    buffer_load_dwordx4 v40, s[20:23], s43 offen offset:0 nt lds
    s_waitcnt vmcnt(20)
    buffer_load_dwordx4 v41, s[20:23], s43 offen offset:1024 nt lds
    s_waitcnt vmcnt(20)
    buffer_load_dwordx4 v42, s[20:23], s43 offen offset:2048 nt lds
    s_waitcnt vmcnt(20)
    buffer_load_dwordx4 v43, s[20:23], s43 offen offset:3072 nt lds
    s_add_u32 m0, s44, 4096
    s_add_u32 s43, s42, 16384
    s_waitcnt vmcnt(20)
    buffer_load_dwordx4 v40, s[20:23], s43 offen offset:0 nt lds
    s_waitcnt vmcnt(20)
    buffer_load_dwordx4 v41, s[20:23], s43 offen offset:1024 nt lds
    s_waitcnt vmcnt(20)
    buffer_load_dwordx4 v42, s[20:23], s43 offen offset:2048 nt lds
    s_waitcnt vmcnt(20)
    buffer_load_dwordx4 v43, s[20:23], s43 offen offset:3072 nt lds
    s_add_u32 m0, s44, 8192
    s_add_u32 s43, s42, 2048
    s_waitcnt vmcnt(20)
    buffer_load_dwordx4 v40, s[20:23], s43 offen offset:0 nt lds
    s_waitcnt vmcnt(20)
    buffer_load_dwordx4 v41, s[20:23], s43 offen offset:1024 nt lds
    s_waitcnt vmcnt(20)
    buffer_load_dwordx4 v42, s[20:23], s43 offen offset:2048 nt lds
    s_waitcnt vmcnt(20)
    buffer_load_dwordx4 v43, s[20:23], s43 offen offset:3072 nt lds
    s_cmp_lg_u32 s47, s49
    s_cbranch_scc1 L_nx2
    s_barrier
L_nx2:
    s_add_u32 m0, s44, 12288
    s_add_u32 s43, s42, 18432
    s_waitcnt vmcnt(20)
    buffer_load_dwordx4 v40, s[20:23], s43 offen offset:0 nt lds
    s_waitcnt vmcnt(20)
    buffer_load_dwordx4 v41, s[20:23], s43 offen offset:1024 nt lds
    s_waitcnt vmcnt(20)
    buffer_load_dwordx4 v42, s[20:23], s43 offen offset:2048 nt lds
    s_waitcnt vmcnt(20)
    buffer_load_dwordx4 v43, s[20:23], s43 offen offset:3072 nt lds
    s_add_u32 m0, s44, 16384
    s_add_u32 s43, s42, 1024
    s_waitcnt vmcnt(20)
    buffer_load_dwordx4 v40, s[20:23], s43 offen offset:0 nt lds
    s_waitcnt vmcnt(20)
    buffer_load_dwordx4 v41, s[20:23], s43 offen offset:1024 nt lds
    s_waitcnt vmcnt(20)
    buffer_load_dwordx4 v42, s[20:23], s43 offen offset:2048 nt lds
    s_waitcnt vmcnt(20)
    buffer_load_dwordx4 v43, s[20:23], s43 offen offset:3072 nt lds
    s_add_u32 m0, s44, 20480
    s_add_u32 s43, s42, 17408
    s_waitcnt vmcnt(20)
    buffer_load_dwordx4 v40, s[20:23], s43 offen offset:0 nt lds
    s_barrier
    s_waitcnt vmcnt(20)
    buffer_load_dwordx4 v41, s[20:23], s43 offen offset:1024 nt lds
    s_waitcnt vmcnt(20)
    buffer_load_dwordx4 v42, s[20:23], s43 offen offset:2048 nt lds
    s_waitcnt vmcnt(20)
    buffer_load_dwordx4 v43, s[20:23], s43 offen offset:3072 nt lds
    s_add_u32 m0, s44, 24576
    s_add_u32 s43, s42, 3072
    s_waitcnt vmcnt(20)
    buffer_load_dwordx4 v40, s[20:23], s43 offen offset:0 nt lds
    s_waitcnt vmcnt(20)
    buffer_load_dwordx4 v41, s[20:23], s43 offen offset:1024 nt lds
    s_waitcnt vmcnt(20)
    buffer_load_dwordx4 v42, s[20:23], s43 offen offset:2048 nt lds
    s_waitcnt vmcnt(20)
    buffer_load_dwordx4 v43, s[20:23], s43 offen offset:3072 nt lds
    s_add_u32 m0, s44, 28672
    s_add_u32 s43, s42, 19456
    s_waitcnt vmcnt(20)
    buffer_load_dwordx4 v40, s[20:23], s43 offen offset:0 nt lds
    s_waitcnt vmcnt(20)
    buffer_load_dwordx4 v41, s[20:23], s43 offen offset:1024 nt lds
    s_waitcnt vmcnt(20)
    buffer_load_dwordx4 v42, s[20:23], s43 offen offset:2048 nt lds
    s_waitcnt vmcnt(20)
    buffer_load_dwordx4 v43, s[20:23], s43 offen offset:3072 nt lds
    s_add_u32 s44, s44, 32768
    s_cmp_eq_u32 s44, 98304
    s_cselect_b32 s44, 0, s44
    s_or_b32 s42, s42, 0xffe17fff
    s_add_u32 s42, s42, 1
    s_and_b32 s42, s42, 0x1e8000
    s_or_b32 s42, s42, s48
    s_add_u32 s50, s47, 1
    s_bitcmp1_b64 s[84:85], s47
    s_mov_b32 s47, s50
    s_cbranch_scc0 L_lv2
    s_branch L_event
L_lv3:
    s_add_u32 m0, s44, 0
    s_add_u32 s43, s42, 0
    s_waitcnt vmcnt(22)
    buffer_load_dwordx4 v40, s[20:23], s43 offen offset:0 nt lds
    s_waitcnt vmcnt(22)
    buffer_load_dwordx4 v41, s[20:23], s43 offen offset:1024 nt lds
    s_waitcnt vmcnt(22)
    buffer_load_dwordx4 v42, s[20:23], s43 offen offset:2048 nt lds
    s_waitcnt vmcnt(22)
    buffer_load_dwordx4 v43, s[20:23], s43 offen offset:3072 nt lds
    s_add_u32 m0, s44, 4096
    s_add_u32 s43, s42, 16384
    s_waitcnt vmcnt(22)
    buffer_load_dwordx4 v40, s[20:23], s43 offen offset:0 nt lds
    s_waitcnt vmcnt(22)
    buffer_load_dwordx4 v41, s[20:23], s43 offen offset:1024 nt lds
    s_waitcnt vmcnt(22)
    buffer_load_dwordx4 v42, s[20:23], s43 offen offset:2048 nt lds
    s_waitcnt vmcnt(22)
    buffer_load_dwordx4 v43, s[20:23], s43 offen offset:3072 nt lds
    s_add_u32 m0, s44, 8192
    s_add_u32 s43, s42, 2048
    s_waitcnt vmcnt(22)
    buffer_load_dwordx4 v40, s[20:23], s43 offen offset:0 nt lds
    s_waitcnt vmcnt(22)
    buffer_load_dwordx4 v41, s[20:23], s43 offen offset:1024 nt lds
    s_waitcnt vmcnt(22)
    buffer_load_dwordx4 v42, s[20:23], s43 offen offset:2048 nt lds
    s_waitcnt vmcnt(22)
    buffer_load_dwordx4 v43, s[20:23], s43 offen offset:3072 nt lds
    s_cmp_lg_u32 s47, s49
    s_cbranch_scc1 L_nx3
    s_barrier
L_nx3:
    s_add_u32 m0, s44, 12288
    s_add_u32 s43, s42, 18432
    s_waitcnt vmcnt(22)
    buffer_load_dwordx4 v40, s[20:23], s43 offen offset:0 nt lds
    s_waitcnt vmcnt(22)
    buffer_load_dwordx4 v41, s[20:23], s43 offen offset:1024 nt lds
    s_waitcnt vmcnt(22)
    buffer_load_dwordx4 v42, s[20:23], s43 offen offset:2048 nt lds
    s_waitcnt vmcnt(22)
    buffer_load_dwordx4 v43, s[20:23], s43 offen offset:3072 nt lds
    s_add_u32 m0, s44, 16384
    s_add_u32 s43, s42, 1024
    s_waitcnt vmcnt(22)
    buffer_load_dwordx4 v40, s[20:23], s43 offen offset:0 nt lds
    s_waitcnt vmcnt(22)
    buffer_load_dwordx4 v41, s[20:23], s43 offen offset:1024 nt lds
    s_waitcnt vmcnt(22)
    buffer_load_dwordx4 v42, s[20:23], s43 offen offset:2048 nt lds
    s_waitcnt vmcnt(22)
    buffer_load_dwordx4 v43, s[20:23], s43 offen offset:3072 nt lds
    s_add_u32 m0, s44, 20480
    s_add_u32 s43, s42, 17408
    s_waitcnt vmcnt(22)
    buffer_load_dwordx4 v40, s[20:23], s43 offen offset:0 nt lds
    s_waitcnt vmcnt(22)
    buffer_load_dwordx4 v41, s[20:23], s43 offen offset:1024 nt lds
    s_waitcnt vmcnt(22)
    buffer_load_dwordx4 v42, s[20:23], s43 offen offset:2048 nt lds
    s_barrier
    s_waitcnt vmcnt(22)
    buffer_load_dwordx4 v43, s[20:23], s43 offen offset:3072 nt lds
    s_add_u32 m0, s44, 24576
    s_add_u32 s43, s42, 3072
    s_waitcnt vmcnt(22)
    buffer_load_dwordx4 v40, s[20:23], s43 offen offset:0 nt lds
    s_waitcnt vmcnt(22)
    buffer_load_dwordx4 v41, s[20:23], s43 offen offset:1024 nt lds
    s_waitcnt vmcnt(22)
    buffer_load_dwordx4 v42, s[20:23], s43 offen offset:2048 nt lds
    s_waitcnt vmcnt(22)
    buffer_load_dwordx4 v43, s[20:23], s43 offen offset:3072 nt lds
    s_add_u32 m0, s44, 28672
    s_add_u32 s43, s42, 19456
    s_waitcnt vmcnt(22)
    buffer_load_dwordx4 v40, s[20:23], s43 offen offset:0 nt lds
    s_waitcnt vmcnt(22)
    buffer_load_dwordx4 v41, s[20:23], s43 offen offset:1024 nt lds
    s_waitcnt vmcnt(22)
    buffer_load_dwordx4 v42, s[20:23], s43 offen offset:2048 nt lds
    s_waitcnt vmcnt(22)
    buffer_load_dwordx4 v43, s[20:23], s43 offen offset:3072 nt lds
    s_add_u32 s44, s44, 32768
    s_cmp_eq_u32 s44, 98304
    s_cselect_b32 s44, 0, s44
    s_or_b32 s42, s42, 0xffe17fff
    s_add_u32 s42, s42, 1
    s_and_b32 s42, s42, 0x1e8000
    s_or_b32 s42, s42, s48
    s_add_u32 s50, s47, 1
    s_bitcmp1_b64 s[84:85], s47
    s_mov_b32 s47, s50
    s_cbranch_scc0 L_lv3
    s_branch L_event
L_lv4:
    s_add_u32 m0, s44, 0
    s_add_u32 s43, s42, 0
    s_waitcnt vmcnt(27)
    buffer_load_dwordx4 v40, s[20:23], s43 offen offset:0 nt lds
    s_waitcnt vmcnt(27)
    buffer_load_dwordx4 v41, s[20:23], s43 offen offset:1024 nt lds
    s_waitcnt vmcnt(27)
    buffer_load_dwordx4 v42, s[20:23], s43 offen offset:2048 nt lds
    s_waitcnt vmcnt(27)
    buffer_load_dwordx4 v43, s[20:23], s43 offen offset:3072 nt lds
    s_add_u32 m0, s44, 4096
    s_add_u32 s43, s42, 16384
    s_waitcnt vmcnt(27)
    buffer_load_dwordx4 v40, s[20:23], s43 offen offset:0 nt lds
    s_waitcnt vmcnt(27)
    buffer_load_dwordx4 v41, s[20:23], s43 offen offset:1024 nt lds
    s_waitcnt vmcnt(27)
    buffer_load_dwordx4 v42, s[20:23], s43 offen offset:2048 nt lds
    s_waitcnt vmcnt(27)
    buffer_load_dwordx4 v43, s[20:23], s43 offen offset:3072 nt lds
    s_add_u32 m0, s44, 8192
    s_add_u32 s43, s42, 2048
    s_waitcnt vmcnt(27)
    buffer_load_dwordx4 v40, s[20:23], s43 offen offset:0 nt lds
    s_waitcnt vmcnt(27)
    buffer_load_dwordx4 v41, s[20:23], s43 offen offset:1024 nt lds
    s_waitcnt vmcnt(27)
    buffer_load_dwordx4 v42, s[20:23], s43 offen offset:2048 nt lds
    s_waitcnt vmcnt(27)
    buffer_load_dwordx4 v43, s[20:23], s43 offen offset:3072 nt lds
    s_cmp_lg_u32 s47, s49
    s_cbranch_scc1 L_nx4
    s_barrier
L_nx4:
    s_add_u32 m0, s44, 12288
    s_add_u32 s43, s42, 18432
    s_waitcnt vmcnt(27)
    buffer_load_dwordx4 v40, s[20:23], s43 offen offset:0 nt lds
    s_waitcnt vmcnt(27)
    buffer_load_dwordx4 v41, s[20:23], s43 offen offset:1024 nt lds
    s_waitcnt vmcnt(27)
    buffer_load_dwordx4 v42, s[20:23], s43 offen offset:2048 nt lds
    s_waitcnt vmcnt(27)
    buffer_load_dwordx4 v43, s[20:23], s43 offen offset:3072 nt lds
    s_add_u32 m0, s44, 16384
    s_add_u32 s43, s42, 1024
    s_waitcnt vmcnt(27)
    buffer_load_dwordx4 v40, s[20:23], s43 offen offset:0 nt lds
    s_waitcnt vmcnt(27)
    buffer_load_dwordx4 v41, s[20:23], s43 offen offset:1024 nt lds
    s_waitcnt vmcnt(27)
    buffer_load_dwordx4 v42, s[20:23], s43 offen offset:2048 nt lds
    s_waitcnt vmcnt(27)
    buffer_load_dwordx4 v43, s[20:23], s43 offen offset:3072 nt lds
    s_add_u32 m0, s44, 20480
    s_add_u32 s43, s42, 17408
    s_waitcnt vmcnt(27)
    buffer_load_dwordx4 v40, s[20:23], s43 offen offset:0 nt lds
    s_waitcnt vmcnt(27)
    buffer_load_dwordx4 v41, s[20:23], s43 offen offset:1024 nt lds
    s_waitcnt vmcnt(27)
    buffer_load_dwordx4 v42, s[20:23], s43 offen offset:2048 nt lds
    s_waitcnt vmcnt(27)
    buffer_load_dwordx4 v43, s[20:23], s43 offen offset:3072 nt lds
    s_add_u32 m0, s44, 24576
    s_add_u32 s43, s42, 3072
    s_waitcnt vmcnt(27)
    buffer_load_dwordx4 v40, s[20:23], s43 offen offset:0 nt lds
    s_waitcnt vmcnt(27)
    buffer_load_dwordx4 v41, s[20:23], s43 offen offset:1024 nt lds
    s_waitcnt vmcnt(27)
    buffer_load_dwordx4 v42, s[20:23], s43 offen offset:2048 nt lds
    s_waitcnt vmcnt(27)
    buffer_load_dwordx4 v43, s[20:23], s43 offen offset:3072 nt lds
    s_barrier
    s_add_u32 m0, s44, 28672
    s_add_u32 s43, s42, 19456
    s_waitcnt vmcnt(27)
    buffer_load_dwordx4 v40, s[20:23], s43 offen offset:0 nt lds
    s_waitcnt vmcnt(27)
    buffer_load_dwordx4 v41, s[20:23], s43 offen offset:1024 nt lds
    s_waitcnt vmcnt(27)
    buffer_load_dwordx4 v42, s[20:23], s43 offen offset:2048 nt lds
    s_waitcnt vmcnt(27)
    buffer_load_dwordx4 v43, s[20:23], s43 offen offset:3072 nt lds
    s_add_u32 s44, s44, 32768
    s_cmp_eq_u32 s44, 98304
    s_cselect_b32 s44, 0, s44
    s_or_b32 s42, s42, 0xffe17fff
    s_add_u32 s42, s42, 1
    s_and_b32 s42, s42, 0x1e8000
    s_or_b32 s42, s42, s48
    s_add_u32 s50, s47, 1
    s_bitcmp1_b64 s[84:85], s47
    s_mov_b32 s47, s50
    s_cbranch_scc0 L_lv4
    s_branch L_event
L_lv5:
    s_add_u32 m0, s44, 0
    s_add_u32 s43, s42, 0
    s_waitcnt vmcnt(31)
    buffer_load_dwordx4 v40, s[20:23], s43 offen offset:0 nt lds
    s_waitcnt vmcnt(31)
    buffer_load_dwordx4 v41, s[20:23], s43 offen offset:1024 nt lds
    s_waitcnt vmcnt(31)
    buffer_load_dwordx4 v42, s[20:23], s43 offen offset:2048 nt lds
    s_waitcnt vmcnt(31)
    buffer_load_dwordx4 v43, s[20:23], s43 offen offset:3072 nt lds
    s_add_u32 m0, s44, 4096
    s_add_u32 s43, s42, 16384
    s_waitcnt vmcnt(31)
    buffer_load_dwordx4 v40, s[20:23], s43 offen offset:0 nt lds
    s_waitcnt vmcnt(31)
    buffer_load_dwordx4 v41, s[20:23], s43 offen offset:1024 nt lds
    s_waitcnt vmcnt(31)
    buffer_load_dwordx4 v42, s[20:23], s43 offen offset:2048 nt lds
    s_waitcnt vmcnt(31)
    buffer_load_dwordx4 v43, s[20:23], s43 offen offset:3072 nt lds
    s_add_u32 m0, s44, 8192
    s_add_u32 s43, s42, 2048
    s_waitcnt vmcnt(31)
    buffer_load_dwordx4 v40, s[20:23], s43 offen offset:0 nt lds
    s_waitcnt vmcnt(31)
    buffer_load_dwordx4 v41, s[20:23], s43 offen offset:1024 nt lds
    s_waitcnt vmcnt(31)
    buffer_load_dwordx4 v42, s[20:23], s43 offen offset:2048 nt lds
    s_waitcnt vmcnt(31)
    buffer_load_dwordx4 v43, s[20:23], s43 offen offset:3072 nt lds
    s_cmp_lg_u32 s47, s49
    s_cbranch_scc1 L_nx5
    s_barrier
L_nx5:
    s_add_u32 m0, s44, 12288
    s_add_u32 s43, s42, 18432
    s_waitcnt vmcnt(31)
    buffer_load_dwordx4 v40, s[20:23], s43 offen offset:0 nt lds
    s_waitcnt vmcnt(31)
    buffer_load_dwordx4 v41, s[20:23], s43 offen offset:1024 nt lds
    s_waitcnt vmcnt(31)
    buffer_load_dwordx4 v42, s[20:23], s43 offen offset:2048 nt lds
    s_waitcnt vmcnt(31)
    buffer_load_dwordx4 v43, s[20:23], s43 offen offset:3072 nt lds
    s_add_u32 m0, s44, 16384
    s_add_u32 s43, s42, 1024
    s_waitcnt vmcnt(31)
    buffer_load_dwordx4 v40, s[20:23], s43 offen offset:0 nt lds
    s_waitcnt vmcnt(31)
    buffer_load_dwordx4 v41, s[20:23], s43 offen offset:1024 nt lds
    s_waitcnt vmcnt(31)
    buffer_load_dwordx4 v42, s[20:23], s43 offen offset:2048 nt lds
    s_waitcnt vmcnt(31)
    buffer_load_dwordx4 v43, s[20:23], s43 offen offset:3072 nt lds
    s_add_u32 m0, s44, 20480
    s_add_u32 s43, s42, 17408
    s_waitcnt vmcnt(31)
    buffer_load_dwordx4 v40, s[20:23], s43 offen offset:0 nt lds
    s_waitcnt vmcnt(31)
    buffer_load_dwordx4 v41, s[20:23], s43 offen offset:1024 nt lds
    s_waitcnt vmcnt(31)
    buffer_load_dwordx4 v42, s[20:23], s43 offen offset:2048 nt lds
    s_waitcnt vmcnt(31)
    buffer_load_dwordx4 v43, s[20:23], s43 offen offset:3072 nt lds
    s_add_u32 m0, s44, 24576
    s_add_u32 s43, s42, 3072
    s_waitcnt vmcnt(31)
    buffer_load_dwordx4 v40, s[20:23], s43 offen offset:0 nt lds
    s_waitcnt vmcnt(31)
    buffer_load_dwordx4 v41, s[20:23], s43 offen offset:1024 nt lds
    s_waitcnt vmcnt(31)
    buffer_load_dwordx4 v42, s[20:23], s43 offen offset:2048 nt lds
    s_waitcnt vmcnt(31)
    buffer_load_dwordx4 v43, s[20:23], s43 offen offset:3072 nt lds
    s_add_u32 m0, s44, 28672
    s_add_u32 s43, s42, 19456
    s_waitcnt vmcnt(31)
    buffer_load_dwordx4 v40, s[20:23], s43 offen offset:0 nt lds
    s_waitcnt vmcnt(31)
    buffer_load_dwordx4 v41, s[20:23], s43 offen offset:1024 nt lds
    s_waitcnt vmcnt(31)
    buffer_load_dwordx4 v42, s[20:23], s43 offen offset:2048 nt lds
    s_waitcnt vmcnt(31)
    buffer_load_dwordx4 v43, s[20:23], s43 offen offset:3072 nt lds
    s_barrier
    s_add_u32 s44, s44, 32768
    s_cmp_eq_u32 s44, 98304
    s_cselect_b32 s44, 0, s44
    s_or_b32 s42, s42, 0xffe17fff
    s_add_u32 s42, s42, 1
    s_and_b32 s42, s42, 0x1e8000
    s_or_b32 s42, s42, s48
    s_add_u32 s50, s47, 1
    s_bitcmp1_b64 s[84:85], s47
    s_mov_b32 s47, s50
    s_cbranch_scc0 L_lv5
L_event:
    s_lshl_b32 s50, s95, 1
    s_cmp_eq_u32 s47, s50
    s_cbranch_scc1 L_half
    s_cmp_lg_u32 s47, s95
    s_cbranch_scc1 L_nosw
    s_add_u32 s20, s8, s45
    s_addc_u32 s21, s9, 0
    s_lshl_b32 s42, s41, 15
    s_or_b32 s42, s42, s48
    v_lshlrev_b32 v0, 4, v96
    v_and_b32 v100, 0x30, v96
    v_lshlrev_b32 v100, 2, v100
    v_xor_b32 v40, v0, v100
    v_add_u32 v41, 3072, v40
    v_add_u32 v42, 6144, v40
    v_add_u32 v43, 9216, v40
L_nosw:
    s_cmp_lg_u32 s47, s92
    s_cbranch_scc1 L_noapply
    s_waitcnt lgkmcnt(0)
    s_sub_u32 s93, s93, s96
    s_min_u32 s93, s93, 8
    s_mul_i32 s93, s93, 3
    s_lshr_b32 s93, s94, s93
    s_and_b32 s88, s93, 7
L_noapply:
    s_bitcmp1_b64 s[86:87], s47
    s_cbranch_scc0 L_nocp
    s_waitcnt lgkmcnt(0)
    s_mov_b64 s[66:67], s[98:99]
    s_mov_b32 s96, s97
    s_add_u32 s92, s47, 1
    s_and_b32 s50, s89, 3
    s_cbranch_scc1 L_reader
    s_mov_b32 s93, 1
    s_atomic_add s93, s[66:67], 0 glc
    s_mov_b32 s94, 0x3691248
    s_cmp_ge_u32 s47, 59
    s_cselect_b32 s94, 0x48d1240, s94
    s_branch L_rot
L_reader:
    s_load_dword s93, s[66:67], 0 glc
    s_mov_b32 s94, 0x3491248
    s_cmp_ge_u32 s47, 59
    s_cselect_b32 s94, 0x48d1240, s94
L_rot:
    s_add_u32 s89, s89, s90
    s_and_b32 s50, s89, 28
    s_mul_i32 s50, s50, 64
    s_add_u32 s50, s50, s91
    s_add_u32 s98, s52, s50
    s_addc_u32 s99, s53, 0
    s_add_u32 s91, s91, 2048
    s_load_dword s97, s[98:99], 0 glc
L_nocp:
    s_mul_i32 s50, s47, s41
    s_cmp_ge_u32 s50, 62
    s_cbranch_scc1 L_lv5
    s_cmp_eq_u32 s88, 0
    s_cbranch_scc1 L_lv0
    s_cmp_eq_u32 s88, 2
    s_cbranch_scc1 L_lv2
    s_cmp_eq_u32 s88, 3
    s_cbranch_scc1 L_lv3
    s_cmp_eq_u32 s88, 4
    s_cbranch_scc1 L_lv4
    s_branch L_lv1
L_h2:
    s_waitcnt vmcnt(16)
    s_barrier
    s_waitcnt vmcnt(0)
    s_barrier
    s_endpgm
.p2align 6
L_cons:
    v_and_b32 v96, 63, v0
    s_lshr_b32 s40, s2, 4
    s_lshl_b32 s40, s40, 3
    s_and_b32 s50, s2, 7
    s_or_b32 s40, s40, s50
    s_bfe_u32 s41, s2, 0x10003
    s_sub_u32 s59, s3, 1
    v_lshrrev_b32 v97, 5, v96
    v_and_b32 v98, 31, v96
    s_lshl_b32 s64, s41, 3
    s_xor_b32 s65, s64, 8
    s_mul_i32 s50, s40, 13568
    s_add_u32 s50, s50, 275456
    s_waitcnt lgkmcnt(0)
    s_add_u32 s66, s52, s50
    s_addc_u32 s67, s53, 0
    s_cmp_lg_u32 s59, 4
    s_cbranch_scc1 L_nohs
    s_lshl_b32 s62, 1, s64
    s_atomic_xor s62, s[66:67], 0 glc
L_nohs:
    v_and_b32 v1, 15, v98
    v_xor_b32 v1, v1, v97
    v_lshlrev_b32 v1, 4, v1
    v_lshl_add_u32 v1, v98, 8, v1
    v_add_u32 v88, 98304, v1
    v_xor_b32 v89, 32, v88
    v_xor_b32 v90, 64, v88
    v_xor_b32 v91, 96, v88
    v_xor_b32 v92, 128, v88
    v_xor_b32 v93, 160, v88
    v_xor_b32 v94, 192, v88
    v_xor_b32 v95, 224, v88
    v_bfe_u32 v6, v96, 2, 2
    v_lshl_add_u32 v1, v97, 2, v6
    v_lshlrev_b32 v2, 8, v1
    v_xor_b32 v6, s59, v6
    v_and_b32 v6, 3, v6
    v_lshl_add_u32 v2, v6, 6, v2
    v_and_b32 v6, 3, v96
    v_lshl_add_u32 v2, v6, 3, v2
    v_and_b32 v6, 16, v96
    v_lshl_add_u32 v2, v6, 1, v2
    v_lshlrev_b32 v3, 4, v96
    v_add_u32 v3, 98304, v3
    v_mov_b32 v4, 0
    v_lshlrev_b32 v5, 3, v98
    v_add_u32 v5, 138240, v5
    s_mov_b32 s61, 98304
    s_mov_b32 s46, 0x3e0293ee
    s_add_u32 s47, s41, 32
    s_add_u32 s93, s59, 2
    s_sub_u32 s50, s93, 7
    s_cselect_b32 s93, s93, s50
    s_mov_b32 s44, 0
    s_mov_b32 s48, s93
    s_mov_b32 s49, 0
    s_mov_b32 s63, 0
    s_mov_b32 s68, 1
    s_mov_b32 s70, 5
    s_mul_i32 s50, s59, 2432
    s_add_u32 s50, s50, 114688
    v_lshl_add_u32 v99, v98, 2, s50
    v_mov_b32 v103, 0
    v_mov_b32 v101, 0xff61b1e6
    v_mov_b32 v102, v101
    s_mul_i32 s50, s40, 13568
    s_mul_i32 s51, s59, 3328
    s_add_u32 s50, s50, s51
    s_add_u32 s50, s50, 262144
    s_add_u32 s24, s52, s50
    s_addc_u32 s25, s53, 0
    s_movk_i32 s26, 3328
    s_mov_b32 s27, 0x20000
    s_mov_b32 s32, s16
    s_mov_b32 s33, s17
    s_mov_b32 s34, 0x100000
    s_mov_b32 s35, 0x20000
    s_lshl_b32 s50, s40, 13
    s_lshl_b32 s51, s59, 6
    s_add_u32 s69, s50, s51
    s_barrier
    ds_read_b128 v[8:11], v88
    ds_read_b128 v[12:15], v89
    ds_read_b128 v[16:19], v90
    ds_read_b128 v[20:23], v91
    ds_read_b128 v[24:27], v92
    ds_read_b128 v[28:31], v93
    ds_read_b128 v[32:35], v94
    ds_read_b128 v[36:39], v95
    s_waitcnt lgkmcnt(0)
    s_branch L_kgo
L_kr:
    s_barrier
L_kgo:
    s_cmp_gt_u32 s48, s68
    s_cbranch_scc1 L_kidle
    s_lshl_b32 s50, s48, 13
    s_add_u32 s50, s50, s44
    s_mov_b32 s60, s49
    s_add_u32 s49, s49, 8
L_ktile:
    s_sub_u32 s51, s50, s61
    s_mov_b32 s61, s50
    v_add_u32 v88, s51, v88
    ds_read_b128 v[40:43], v88
    v_add_u32 v89, s51, v89
    ds_read_b128 v[44:47], v89
    v_add_u32 v90, s51, v90
    ds_read_b128 v[48:51], v90
    v_add_u32 v91, s51, v91
    ds_read_b128 v[52:55], v91
    v_add_u32 v92, s51, v92
    ds_read_b128 v[56:59], v92
    v_add_u32 v93, s51, v93
    ds_read_b128 v[60:63], v93
    v_add_u32 v94, s51, v94
    ds_read_b128 v[64:67], v94
    v_add_u32 v95, s51, v95
    ds_read_b128 v[68:71], v95
    s_lshl_b32 s50, s60, 4
    v_add_u32 v100, s50, v99
    s_cmp_gt_u32 s48, 3
    s_waitcnt lgkmcnt(7)
    s_cbranch_scc1 L_kbias
    v_mfma_f32_32x32x16_bf16 v[72:87], v[40:43], v[8:11], 0
L_k1:
    s_waitcnt lgkmcnt(6)
    v_mfma_f32_32x32x16_bf16 v[72:87], v[44:47], v[12:15], v[72:87]
    s_waitcnt lgkmcnt(5)
    v_mfma_f32_32x32x16_bf16 v[72:87], v[48:51], v[16:19], v[72:87]
    s_waitcnt lgkmcnt(4)
    v_mfma_f32_32x32x16_bf16 v[72:87], v[52:55], v[20:23], v[72:87]
    s_waitcnt lgkmcnt(3)
    v_mfma_f32_32x32x16_bf16 v[72:87], v[56:59], v[24:27], v[72:87]
    s_waitcnt lgkmcnt(2)
    v_mfma_f32_32x32x16_bf16 v[72:87], v[60:63], v[28:31], v[72:87]
    s_waitcnt lgkmcnt(1)
    v_mfma_f32_32x32x16_bf16 v[72:87], v[64:67], v[32:35], v[72:87]
    s_waitcnt lgkmcnt(0)
    v_mfma_f32_32x32x16_bf16 v[72:87], v[68:71], v[36:39], v[72:87]
    s_nop 11
    v_max3_f32 v1, v72, v73, v101
    v_max3_f32 v6, v74, v75, v76
    v_max3_f32 v1, v77, v78, v1
    v_max3_f32 v6, v79, v80, v6
    v_max3_f32 v1, v81, v82, v1
    v_max3_f32 v6, v83, v84, v6
    v_max3_f32 v1, v85, v86, v1
    v_max3_f32 v1, v87, v6, v1
    v_mov_b32 v6, v1
    s_nop 1
    v_permlane32_swap_b32 v1, v6
    v_max_f32 v101, v1, v6
    v_mul_f32 v1, s46, v101
    v_ceil_f32 v1, v1
    v_sub_f32 v7, v102, v1
    v_mov_b32 v102, v1
    ds_write_b32 v100, v1
    v_exp_f32 v7, v7
    v_fma_f32 v72, v72, s46, -v102
    v_fma_f32 v73, v73, s46, -v102
    v_fma_f32 v74, v74, s46, -v102
    v_fma_f32 v75, v75, s46, -v102
    v_fma_f32 v76, v76, s46, -v102
    v_fma_f32 v77, v77, s46, -v102
    v_fma_f32 v78, v78, s46, -v102
    v_fma_f32 v79, v79, s46, -v102
    v_fma_f32 v80, v80, s46, -v102
    v_fma_f32 v81, v81, s46, -v102
    v_fma_f32 v82, v82, s46, -v102
    v_fma_f32 v83, v83, s46, -v102
    v_fma_f32 v84, v84, s46, -v102
    v_fma_f32 v85, v85, s46, -v102
    v_fma_f32 v86, v86, s46, -v102
    v_fma_f32 v87, v87, s46, -v102
    v_exp_f32 v72, v72
    v_exp_f32 v73, v73
    v_exp_f32 v74, v74
    v_exp_f32 v75, v75
    v_exp_f32 v76, v76
    v_exp_f32 v77, v77
    v_exp_f32 v78, v78
    v_exp_f32 v79, v79
    v_exp_f32 v80, v80
    v_exp_f32 v81, v81
    v_exp_f32 v82, v82
    v_exp_f32 v83, v83
    v_exp_f32 v84, v84
    v_exp_f32 v85, v85
    v_exp_f32 v86, v86
    v_exp_f32 v87, v87
    v_mul_f32 v103, v103, v7
    s_set_gpr_idx_on s60, gpr_idx(DST)
    s_mov_b32 s50, 0x3f803f80
    v_cvt_pk_bf16_f32 v104, v72, v73
    v_cvt_pk_bf16_f32 v105, v74, v75
    v_cvt_pk_bf16_f32 v106, v76, v77
    v_cvt_pk_bf16_f32 v107, v78, v79
    v_cvt_pk_bf16_f32 v108, v80, v81
    v_cvt_pk_bf16_f32 v109, v82, v83
    v_cvt_pk_bf16_f32 v110, v84, v85
    v_cvt_pk_bf16_f32 v111, v86, v87
    s_set_gpr_idx_on s60, gpr_idx(SRC0)
    s_nop 0
    v_dot2_f32_bf16 v103, v104, s50, v103
    v_dot2_f32_bf16 v103, v105, s50, v103
    v_dot2_f32_bf16 v103, v106, s50, v103
    v_dot2_f32_bf16 v103, v107, s50, v103
    v_dot2_f32_bf16 v103, v108, s50, v103
    v_dot2_f32_bf16 v103, v109, s50, v103
    v_dot2_f32_bf16 v103, v110, s50, v103
    v_dot2_f32_bf16 v103, v111, s50, v103
    s_set_gpr_idx_off
L_knext:
    s_add_u32 s48, s48, s70
    s_sub_u32 s50, s48, 7
    s_cselect_b32 s48, s48, s50
    s_mov_b32 s68, 3
    s_mov_b32 s70, 3
    s_add_u32 s44, s44, 32768
    s_cmp_eq_u32 s44, 98304
    s_cselect_b32 s44, 0, s44
    s_sub_u32 s47, s47, 1
    s_cmp_lg_u32 s47, 0
    s_cbranch_scc1 L_kr
    v_mov_b32 v6, v103
    s_lshl_b32 s50, s59, 8
    v_add_u32 v1, s50, v5
    v_permlane32_swap_b32 v103, v6
    v_add_f32 v103, v103, v6
    ds_write_b64 v1, v[102:103]
    v_mov_b64 v[72:73], 0
    v_mov_b64 v[74:75], 0
    v_mov_b64 v[76:77], 0
    v_mov_b64 v[78:79], 0
    v_mov_b64 v[80:81], 0
    v_mov_b64 v[82:83], 0
    v_mov_b64 v[84:85], 0
    v_mov_b64 v[86:87], 0
    s_lshl_b32 s48, s41, 2
    s_add_u32 s48, s48, 2
    s_add_u32 s47, s41, 32
    s_mov_b32 s61, 0
    s_lshl_b32 s49, s41, 1
    s_sub_u32 s49, s49, 1
    s_waitcnt lgkmcnt(0)
    s_barrier
    ds_read_b32 v40, v5 offset:0
    ds_read_b32 v41, v5 offset:256
    ds_read_b32 v42, v5 offset:512
    ds_read_b32 v43, v5 offset:768
    ds_read_b32 v44, v5 offset:1024
    ds_read_b32 v45, v5 offset:1280
    ds_read_b32 v46, v5 offset:1536
    s_mov_b32 s60, 144
    s_mov_b32 s50, 37888
    s_add_u32 s51, s59, s64
    s_cmp_eq_u32 s51, 5
    s_waitcnt lgkmcnt(0)
    v_max3_f32 v102, v40, v41, v42
    v_max3_f32 v102, v102, v43, v44
    v_max3_f32 v102, v102, v45, v46
    s_cbranch_scc1 L_dump
L_stage:
    s_cmp_eq_u32 s47, 1
    s_cselect_b32 s48, 0, s48
    s_cselect_b32 s68, 1, 3
    s_add_u32 s50, s48, 6
    s_sub_u32 s50, s50, s93
    s_mul_i32 s50, s50, 9363
    s_lshr_b32 s50, s50, 16
    s_lshl_b32 s60, s50, 3
    s_sub_u32 s50, s60, s50
    s_add_u32 s50, s50, s93
    s_sub_u32 s50, s50, s48
    s_cmp_gt_u32 s50, s68
    s_cbranch_scc1 L_vnext
    s_lshl_b32 s50, s50, 11
    s_add_u32 s50, s50, s61
L_dump:
    s_lshl_b32 s51, s60, 4
    v_add_u32 v1, s51, v99
    ds_read_b32 v1, v1
    v_add_u32 v6, s50, v3
    s_waitcnt lgkmcnt(0)
    v_sub_f32 v1, v102, v1
    v_min_f32 v1, 0x437f0000, v1
    v_cvt_u32_f32 v1, v1
    v_mul_u32_u24 v1, 0x800080, v1
    s_set_gpr_idx_on s60, gpr_idx(SRC0)
    s_nop 0
    v_pk_sub_u16 v88, v104, v1 clamp
    v_pk_sub_u16 v89, v105, v1 clamp
    v_pk_sub_u16 v90, v106, v1 clamp
    v_pk_sub_u16 v91, v107, v1 clamp
    v_pk_sub_u16 v92, v108, v1 clamp
    v_pk_sub_u16 v93, v109, v1 clamp
    v_pk_sub_u16 v94, v110, v1 clamp
    v_pk_sub_u16 v95, v111, v1 clamp
    s_set_gpr_idx_off
    ds_write_b128 v6, v[88:91]
    ds_write_b128 v6, v[92:95] offset:1024
L_vnext:
    s_add_u32 s48, s48, 4
    s_cmp_eq_u32 s48, 130
    s_cselect_b32 s48, 2, s48
    v_add_u32 v1, s44, v2
    v_add_u32 v6, s61, v3
    s_xor_b32 s61, s61, 8192
    s_add_u32 s44, s44, 32768
    s_cmp_eq_u32 s44, 98304
    s_cselect_b32 s44, 0, s44
    s_sub_u32 s47, s47, 1
    s_cmp_gt_u32 s59, 3
    s_waitcnt lgkmcnt(0)
    s_cbranch_scc1 L_vside
    s_cmp_eq_u32 s47, s49
    s_cbranch_scc1 L_close
    s_cmp_eq_u32 s47, 0
    s_barrier
L_vbody:
    ds_read_b128 v[8:11], v6 offset:0
    ds_read_b64_tr_b16 v[40:41], v1 offset:0
    ds_read_b64_tr_b16 v[42:43], v1 offset:2048
    ds_read_b128 v[12:15], v6 offset:1024
    ds_read_b64_tr_b16 v[44:45], v1 offset:4096
    ds_read_b64_tr_b16 v[46:47], v1 offset:6144
    ds_read_b128 v[16:19], v6 offset:2048
    ds_read_b64_tr_b16 v[48:49], v1 offset:8192
    ds_read_b64_tr_b16 v[50:51], v1 offset:10240
    ds_read_b128 v[20:23], v6 offset:3072
    ds_read_b64_tr_b16 v[52:53], v1 offset:12288
    ds_read_b64_tr_b16 v[54:55], v1 offset:14336
    s_cbranch_scc1 L_last
    s_waitcnt lgkmcnt(9)
    v_mfma_f32_32x32x16_bf16 v[72:87], v[40:43], v[8:11], v[72:87]
    ds_read_b128 v[24:27], v6 offset:4096
    ds_read_b64_tr_b16 v[56:57], v1 offset:16384
    ds_read_b64_tr_b16 v[58:59], v1 offset:18432
    s_waitcnt lgkmcnt(9)
    v_mfma_f32_32x32x16_bf16 v[72:87], v[44:47], v[12:15], v[72:87]
    ds_read_b128 v[28:31], v6 offset:5120
    ds_read_b64_tr_b16 v[60:61], v1 offset:20480
    ds_read_b64_tr_b16 v[62:63], v1 offset:22528
    s_waitcnt lgkmcnt(9)
    v_mfma_f32_32x32x16_bf16 v[72:87], v[48:51], v[16:19], v[72:87]
    ds_read_b128 v[32:35], v6 offset:6144
    ds_read_b64_tr_b16 v[64:65], v1 offset:24576
    ds_read_b64_tr_b16 v[66:67], v1 offset:26624
    s_waitcnt lgkmcnt(9)
    v_mfma_f32_32x32x16_bf16 v[72:87], v[52:55], v[20:23], v[72:87]
    ds_read_b128 v[36:39], v6 offset:7168
    ds_read_b64_tr_b16 v[68:69], v1 offset:28672
    ds_read_b64_tr_b16 v[70:71], v1 offset:30720
    s_cmp_eq_u32 s47, 1
    s_waitcnt lgkmcnt(9)
    v_mfma_f32_32x32x16_bf16 v[72:87], v[56:59], v[24:27], v[72:87]
    s_waitcnt lgkmcnt(6)
    v_mfma_f32_32x32x16_bf16 v[72:87], v[60:63], v[28:31], v[72:87]
    s_waitcnt lgkmcnt(3)
    v_mfma_f32_32x32x16_bf16 v[72:87], v[64:67], v[32:35], v[72:87]
    s_waitcnt lgkmcnt(0)
    v_mfma_f32_32x32x16_bf16 v[72:87], v[68:71], v[36:39], v[72:87]
    s_cbranch_scc1 L_vnext
    s_cmp_eq_u32 s47, 20
    s_cbranch_scc0 L_stage
    ds_read_b64 v[40:41], v5 offset:0
    ds_read_b64 v[42:43], v5 offset:256
    ds_read_b64 v[44:45], v5 offset:512
    ds_read_b64 v[46:47], v5 offset:768
    ds_read_b64 v[48:49], v5 offset:1024
    ds_read_b64 v[50:51], v5 offset:1280
    ds_read_b64 v[52:53], v5 offset:1536
    v_add_u32 v1, 132096, v2
    ds_read_b128 v[8:11], v3 offset:37888
    ds_read_b64_tr_b16 v[12:13], v1 offset:0
    ds_read_b64_tr_b16 v[14:15], v1 offset:2048
    s_cmp_lg_u32 s41, 0
    s_waitcnt lgkmcnt(0)
    v_sub_f32 v40, v40, v102
    v_sub_f32 v42, v42, v102
    v_sub_f32 v44, v44, v102
    v_sub_f32 v46, v46, v102
    v_sub_f32 v48, v48, v102
    v_sub_f32 v50, v50, v102
    v_sub_f32 v52, v52, v102
    v_exp_f32 v40, v40
    v_exp_f32 v42, v42
    v_exp_f32 v44, v44
    v_exp_f32 v46, v46
    v_exp_f32 v48, v48
    v_exp_f32 v50, v50
    v_exp_f32 v52, v52
    v_mul_f32 v103, v40, v41
    v_fma_f32 v103, v42, v43, v103
    v_fma_f32 v103, v44, v45, v103
    v_fma_f32 v103, v46, v47, v103
    v_fma_f32 v103, v48, v49, v103
    v_fma_f32 v103, v50, v51, v103
    v_fma_f32 v103, v52, v53, v103
    s_cbranch_scc1 L_stage
    v_mfma_f32_32x32x16_bf16 v[72:87], v[12:15], v[8:11], v[72:87]
    s_branch L_stage
L_last:
    v_lshlrev_b32 v90, 4, v96
    v_lshlrev_b32 v91, 3, v98
    v_add_u32 v91, 3072, v91
    s_cmp_lg_u32 s41, 0
    s_cbranch_scc1 L_merge
    buffer_store_dwordx2 v[102:103], v91, s[24:27], 0 offen sc1
    s_waitcnt lgkmcnt(9)
    v_mfma_f32_32x32x16_bf16 v[72:87], v[40:43], v[8:11], v[72:87]
    s_waitcnt lgkmcnt(6)
    v_mfma_f32_32x32x16_bf16 v[72:87], v[44:47], v[12:15], v[72:87]
    s_waitcnt lgkmcnt(3)
    v_mfma_f32_32x32x16_bf16 v[72:87], v[48:51], v[16:19], v[72:87]
    s_waitcnt lgkmcnt(0)
    v_mfma_f32_32x32x16_bf16 v[72:87], v[52:55], v[20:23], v[72:87]
    s_mov_b32 s72, 0x7060501
    s_mov_b32 s73, 0x7060502
    s_mov_b32 s74, 0x7060503
    s_nop 8
    v_perm_b32 v40, v72, v84, s72
    v_perm_b32 v41, v73, v84, s73
    v_perm_b32 v42, v74, v84, s74
    v_perm_b32 v43, v75, v85, s72
    buffer_store_dwordx4 v[40:43], v90, s[24:27], 0 offen offset:0 sc1
    v_perm_b32 v44, v76, v85, s73
    v_perm_b32 v45, v77, v85, s74
    v_perm_b32 v46, v78, v86, s72
    v_perm_b32 v47, v79, v86, s73
    buffer_store_dwordx4 v[44:47], v90, s[24:27], 0 offen offset:1024 sc1
    v_perm_b32 v48, v80, v86, s74
    v_perm_b32 v49, v81, v87, s72
    v_perm_b32 v50, v82, v87, s73
    v_perm_b32 v51, v83, v87, s74
    buffer_store_dwordx4 v[48:51], v90, s[24:27], 0 offen offset:2048 sc1
    s_mov_b32 s50, 8
    s_cmp_lg_u32 s59, 0
    s_waitcnt vmcnt(0)
    s_barrier
    s_cbranch_scc1 L_done
    s_atomic_xor s50, s[66:67], 0
    s_branch L_done
L_close:
    v_lshlrev_b32 v90, 4, v96
    v_lshlrev_b32 v91, 3, v98
    v_add_u32 v91, 3072, v91
    s_barrier
    buffer_load_dwordx2 v[136:137], v91, s[24:27], 0 offen sc1
    buffer_load_dwordx4 v[120:123], v90, s[24:27], 0 offen offset:0 sc1
    buffer_load_dwordx4 v[124:127], v90, s[24:27], 0 offen offset:1024 sc1
    buffer_load_dwordx4 v[128:131], v90, s[24:27], 0 offen offset:2048 sc1
    s_cmp_eq_u32 s47, 0
    s_branch L_vbody
L_merge:
    v_lshlrev_b32 v92, 8, v98
    v_lshl_add_u32 v92, v97, 4, v92
    s_mov_b32 s72, 0x0c04000c
    s_mov_b32 s73, 0x0402010c
    s_waitcnt lgkmcnt(9)
    v_mfma_f32_32x32x16_bf16 v[72:87], v[40:43], v[8:11], v[72:87]
    s_waitcnt lgkmcnt(6)
    v_mfma_f32_32x32x16_bf16 v[72:87], v[44:47], v[12:15], v[72:87]
    s_waitcnt lgkmcnt(3)
    v_mfma_f32_32x32x16_bf16 v[72:87], v[48:51], v[16:19], v[72:87]
    s_waitcnt lgkmcnt(0)
    v_mfma_f32_32x32x16_bf16 v[72:87], v[52:55], v[20:23], v[72:87]
    s_waitcnt vmcnt(0)
    v_max_f32 v1, v102, v136
    v_sub_f32 v138, v102, v1
    v_sub_f32 v140, v136, v1
    v_exp_f32 v138, v138
    v_exp_f32 v140, v140
    v_mul_f32 v1, v138, v103
    v_fma_f32 v1, v140, v137, v1
    v_rcp_f32 v1, v1
    v_perm_b32 v132, v121, v120, s72
    v_perm_b32 v133, v124, v123, s72
    v_perm_b32 v134, v127, v126, s72
    v_perm_b32 v135, v130, v129, s72
    v_perm_b32 v132, v122, v132, s73
    v_perm_b32 v133, v125, v133, s73
    v_perm_b32 v134, v128, v134, s73
    v_perm_b32 v135, v131, v135, s73
    v_mul_f32 v140, v140, v1
    v_mul_f32 v138, v138, v1
    v_pk_mul_f32 v[120:121], v[120:121], v[140:141] op_sel_hi:[1,0]
    v_pk_mul_f32 v[122:123], v[122:123], v[140:141] op_sel_hi:[1,0]
    v_pk_mul_f32 v[124:125], v[124:125], v[140:141] op_sel_hi:[1,0]
    v_pk_mul_f32 v[126:127], v[126:127], v[140:141] op_sel_hi:[1,0]
    v_pk_fma_f32 v[72:73], v[72:73], v[138:139], v[120:121] op_sel_hi:[1,0,1]
    v_pk_fma_f32 v[74:75], v[74:75], v[138:139], v[122:123] op_sel_hi:[1,0,1]
    v_pk_fma_f32 v[76:77], v[76:77], v[138:139], v[124:125] op_sel_hi:[1,0,1]
    v_pk_fma_f32 v[78:79], v[78:79], v[138:139], v[126:127] op_sel_hi:[1,0,1]
    v_cvt_pk_bf16_f32 v40, v72, v73
    v_cvt_pk_bf16_f32 v42, v76, v77
    v_cvt_pk_bf16_f32 v41, v74, v75
    v_cvt_pk_bf16_f32 v43, v78, v79
    v_permlane32_swap_b32 v40, v42
    s_nop 0
    v_permlane32_swap_b32 v41, v43
    buffer_store_dwordx4 v[40:43], v92, s[32:35], s69 offen offset:0
    v_pk_mul_f32 v[128:129], v[128:129], v[140:141] op_sel_hi:[1,0]
    v_pk_mul_f32 v[130:131], v[130:131], v[140:141] op_sel_hi:[1,0]
    v_pk_mul_f32 v[132:133], v[132:133], v[140:141] op_sel_hi:[1,0]
    v_pk_mul_f32 v[134:135], v[134:135], v[140:141] op_sel_hi:[1,0]
    v_pk_fma_f32 v[80:81], v[80:81], v[138:139], v[128:129] op_sel_hi:[1,0,1]
    v_pk_fma_f32 v[82:83], v[82:83], v[138:139], v[130:131] op_sel_hi:[1,0,1]
    v_pk_fma_f32 v[84:85], v[84:85], v[138:139], v[132:133] op_sel_hi:[1,0,1]
    v_pk_fma_f32 v[86:87], v[86:87], v[138:139], v[134:135] op_sel_hi:[1,0,1]
    v_cvt_pk_bf16_f32 v44, v80, v81
    v_cvt_pk_bf16_f32 v46, v84, v85
    v_cvt_pk_bf16_f32 v45, v82, v83
    v_cvt_pk_bf16_f32 v47, v86, v87
    v_permlane32_swap_b32 v44, v46
    s_nop 0
    v_permlane32_swap_b32 v45, v47
    buffer_store_dwordx4 v[44:47], v92, s[32:35], s69 offen offset:32
L_done:
L_end:
    s_endpgm
L_vside:
    s_cmp_eq_u32 s47, 0
    s_cbranch_scc1 L_end
    s_barrier
    s_cmp_lg_u32 s59, 4
    s_cbranch_scc1 L_stage
    s_cmp_eq_u32 s47, 24
    s_cbranch_scc1 L_hsfin
    s_add_u32 s50, s49, 1
    s_cmp_lg_u32 s47, s50
    s_cbranch_scc1 L_stage
    s_mov_b32 s71, 16
L_spoll:
    s_load_dword s50, s[66:67], 0 glc
    s_waitcnt lgkmcnt(0)
    s_xor_b32 s50, s50, s62
    s_bitcmp1_b32 s50, 3
    s_cbranch_scc1 L_seen
    s_sub_u32 s71, s71, 1
    s_cbranch_scc0 L_spoll
    s_mov_b32 s71, 4194304
L_poll:
    global_load_dword v6, v4, s[66:67] sc1
    s_sub_u32 s71, s71, 1
    s_cbranch_scc1 L_seen
    s_waitcnt vmcnt(0)
    v_readfirstlane_b32 s50, v6
    s_xor_b32 s50, s50, s62
    s_bitcmp1_b32 s50, 3
    s_cbranch_scc0 L_poll
L_seen:
    s_barrier
    s_endpgm
L_kbias:
    v_mfma_f32_32x32x16_bf16 v[72:87], v[40:43], v[8:11], v[72:87]
    s_branch L_k1
L_kidle:
    s_cmp_eq_u32 s59, 4
    s_cbranch_scc1 L_hs
    s_add_u32 s50, s59, s64
    s_cmp_lg_u32 s50, 5
    s_cbranch_scc1 L_knext
    s_cmp_eq_u32 s47, 31
    s_cbranch_scc1 L_tree1
    s_cmp_lg_u32 s47, 29
    s_cbranch_scc1 L_knext
    s_mov_b32 s51, 0x5028965f
    v_mov_b32 v6, 0xd028965f
    v_mov_b32 v80, 0xff800000
    v_mov_b32 v81, 0xff800000
    v_mov_b32 v82, 0xff800000
    v_mov_b32 v83, 0xff800000
    v_mov_b32 v84, 0xff800000
    v_mov_b32 v85, 0xff800000
    v_mov_b32 v86, 0xff800000
    v_mov_b32 v87, 0xff800000
    s_waitcnt vmcnt(0)
    v_lshlrev_b32 v72, 16, v248
    v_and_b32 v73, 0xffff0000, v248
    v_lshlrev_b32 v74, 16, v249
    v_and_b32 v75, 0xffff0000, v249
    v_lshlrev_b32 v76, 16, v250
    v_and_b32 v77, 0xffff0000, v250
    v_lshlrev_b32 v78, 16, v251
    v_and_b32 v79, 0xffff0000, v251
    v_fma_f32 v72, v72, s51, v6
    v_fma_f32 v73, v73, s51, v6
    v_fma_f32 v74, v74, s51, v6
    v_fma_f32 v75, v75, s51, v6
    v_fma_f32 v76, v76, s51, v6
    v_fma_f32 v77, v77, s51, v6
    v_fma_f32 v78, v78, s51, v6
    v_fma_f32 v79, v79, s51, v6
    s_mov_b32 s60, 144
    s_mov_b32 s50, 106496
    s_branch L_ktile
L_tree1:
    v_lshlrev_b32 v0, 4, v96
    v_and_b32 v100, 0x30, v96
    v_xor_b32 v40, v0, v100
    v_xor_b32 v41, 64, v40
    v_xor_b32 v42, 128, v40
    v_xor_b32 v43, 192, v40
    s_lshl_b32 s45, s40, 12
    s_movk_i32 s51, 4096
    s_add_u32 s20, s10, s45
    s_addc_u32 s21, s11, 0
    s_mov_b32 s22, 4096
    s_mov_b32 s23, 0x20000
    s_mov_b32 m0, 106496
    s_add_u32 s28, s12, s45
    s_addc_u32 s29, s13, 0
    s_mov_b32 s30, 4096
    s_mov_b32 s31, 0x20000
    buffer_load_dwordx4 v40, s[20:23], 0 offen offset:0 lds
    buffer_load_dwordx4 v41, s[20:23], 0 offen offset:1024 lds
    buffer_load_dwordx4 v42, s[20:23], 0 offen offset:2048 lds
    buffer_load_dwordx4 v43, s[20:23], 0 offen offset:3072 lds
    s_mov_b32 m0, 110592
    s_lshr_b32 s50, s40, 4
    s_lshl_b32 s50, s50, 9
    buffer_load_dwordx4 v40, s[20:23], s51 offen offset:0 lds
    buffer_load_dwordx4 v41, s[20:23], s51 offen offset:1024 lds
    buffer_load_dwordx4 v42, s[20:23], s51 offen offset:2048 lds
    buffer_load_dwordx4 v43, s[20:23], s51 offen offset:3072 lds
    v_lshlrev_b32 v0, 4, v96
    v_and_b32 v100, 0x30, v96
    v_lshlrev_b32 v100, 2, v100
    v_xor_b32 v40, v0, v100
    s_mov_b32 m0, 132096
    s_add_u32 s36, s14, s50
    s_addc_u32 s37, s15, 0
    s_mov_b32 s38, 512
    s_mov_b32 s39, 0x20000
    buffer_load_dwordx4 v40, s[28:31], 0 offen offset:0 lds
    buffer_load_dwordx4 v40, s[28:31], 0 offen offset:1024 lds
    buffer_load_dwordx4 v40, s[28:31], 0 offen offset:2048 lds
    buffer_load_dwordx4 v40, s[28:31], 0 offen offset:3072 lds
    v_and_b32 v6, 15, v98
    v_lshlrev_b32 v6, 5, v6
    v_lshl_add_u32 v6, v97, 3, v6
    buffer_load_dwordx2 v[248:249], v6, s[36:39], 0 offen
    buffer_load_dwordx2 v[250:251], v6, s[36:39], 0 offen offset:16
    s_branch L_knext
L_hs:
    s_cmp_eq_u32 s63, 2
    s_cbranch_scc1 L_knext
    s_cmp_eq_u32 s68, 1
    s_cbranch_scc1 L_knext
    global_load_dword v6, v4, s[66:67] sc1
    s_waitcnt vmcnt(0)
    v_readfirstlane_b32 s50, v6
    s_xor_b32 s50, s50, s62
    s_lshr_b32 s50, s50, s65
    s_and_b32 s51, s50, 3
    s_cbranch_scc0 L_knext
    s_mov_b32 s63, 2
    s_bitcmp1_b32 s50, 0
    s_cbranch_scc0 L_knext
    s_lshl_b32 s94, 2, s64
    s_atomic_xor s94, s[66:67], 0
    s_branch L_knext
L_hsfin:
    s_mov_b32 s71, 4194304
L_hsw:
    s_cmp_eq_u32 s63, 2
    s_cbranch_scc1 L_stage
    s_sub_u32 s71, s71, 1
    s_cbranch_scc1 L_stage
    global_load_dword v6, v4, s[66:67] sc1
    s_waitcnt vmcnt(0)
    v_readfirstlane_b32 s50, v6
    s_xor_b32 s50, s50, s62
    s_lshr_b32 s50, s50, s65
    s_and_b32 s51, s50, 3
    s_cbranch_scc0 L_hsw
    s_mov_b32 s63, 2
    s_bitcmp1_b32 s50, 0
    s_cbranch_scc0 L_stage
    s_lshl_b32 s94, 2, s64
    s_atomic_xor s94, s[66:67], 0
    s_branch L_stage
.section .rodata,"a"
.p2align 6
.amdhsa_kernel standalone__tree_speculative_verify_tree_attention_over_candidate_token_tree__sampling_kernel
  .amdhsa_next_free_vgpr 256
  .amdhsa_next_free_sgpr 100
  .amdhsa_accum_offset 256
  .amdhsa_group_segment_fixed_size 0
  .amdhsa_kernarg_size 72
  .amdhsa_user_sgpr_count 2
  .amdhsa_user_sgpr_kernarg_segment_ptr 1
  .amdhsa_system_sgpr_workgroup_id_x 1
.end_amdhsa_kernel
```
